```python
import torch

def _softmax(x, axis=-1):
    return torch.softmax(x, dim=axis)
def _gelu(x):
    return torch.nn.functional.gelu(x, approximate="tanh")
def _silu(x):
    return torch.nn.functional.silu(x)
def _sigmoid(x):
    return torch.sigmoid(x)
def _layernorm(x, axis=-1, eps=1e-5):
    m = x.mean(dim=axis, keepdim=True)
    v = x.var(dim=axis, keepdim=True, unbiased=False)
    return (x - m) / torch.sqrt(v + eps)
def _scatter_add(tgt, idx, src, axis=0):
    return tgt.clone().index_add_(axis, idx, src)
def _segment_sum(src, seg, n):
    out = torch.zeros((n,) + src.shape[1:], dtype=src.dtype)
    return out.index_add_(0, seg, src)
def _pad(x, pw):
    flat = tuple(v for pair in reversed(pw) for v in pair)
    return torch.nn.functional.pad(x, flat)

kernel_name = 'standalone__sliding_block_cached__decode'

def setup_inputs():

    _w = (lambda a: (lambda t: t.to(torch.bfloat16) if t.is_floating_point() else t)(torch.as_tensor(a)))
    B, Sq, D = 8, 1, 512
    Hq, Hkv, Sk, Dh = 32, 8, 4096, 128
    assert Hq % Hkv == 0, (Hq, Hkv)
    return {
        "x": _w((lambda *s: torch.randn(*s, dtype=torch.bfloat16) * 0.8)(B, Sq, D)),
        "k_cache": _w((lambda *s: torch.randn(*s, dtype=torch.bfloat16) * 0.8)(B, Hkv, Sk, Dh)),
        "v_cache": _w((lambda *s: torch.randn(*s, dtype=torch.bfloat16) * 0.05)(B, Hkv, Sk, Dh)),
        "wq": _w((lambda *s: torch.randn(*s, dtype=torch.bfloat16) * 0.8)(D, Hq * Dh) * (D ** -0.5)),
        "wo": _w((lambda *s: torch.randn(*s, dtype=torch.bfloat16) * 0.05)(Hq * Dh, D) * ((Hq * Dh) ** -0.5)),
    }

def reference(x, k_cache, v_cache, wq, wo):
    B, Sq, D = x.shape
    Hq, Dh = 32, 128
    Hkv, Sk = k_cache.shape[1], k_cache.shape[2]
    W = min(4096, max(256, Sk // 4))
    rep = Hq // Hkv
    q = (lambda x, *d: x.permute(*d))((x @ wq).reshape(B, Sq, Hq, Dh), 0, 2, 1, 3)
    k = (lambda x, n, axis: torch.repeat_interleave(x, n, dim=axis))(k_cache[:, :, Sk - W:, :], rep, axis=1)
    v = (lambda x, n, axis: torch.repeat_interleave(x, n, dim=axis))(v_cache[:, :, Sk - W:, :], rep, axis=1)
    scores = torch.einsum("bhqd,bhkd->bhqk", q, k) * (Dh ** -0.5)
    p = _softmax(scores, axis=-1)
    o = torch.einsum("bhqk,bhkd->bhqd", p, v)
    return (lambda x, *d: x.permute(*d))(o, 0, 2, 1, 3).reshape(B, Sq, Hq * Dh) @ wo
```

```asm
; @launch grid=(256,1,1) block=(512,1,1) lds=159744
.amdgcn_target "amdgcn-amd-amdhsa--gfx950"
.text
.globl standalone__sliding_block_cached__decode_kernel
.p2align 8
.type standalone__sliding_block_cached__decode_kernel,@function
standalone__sliding_block_cached__decode_kernel:
s_load_dwordx16 s[4:19], s[0:1], 0
s_cmp_ge_u32 s2, 256
s_cbranch_scc1 L_end
v_lshrrev_b32 v1, 6, v0
v_and_b32 v0, 63, v0
s_and_b32 s20, s2, 7
v_readfirstlane_b32 s3, v1
s_lshr_b32 s21, s2, 3
v_and_b32 v1, 15, v0
v_lshrrev_b32 v2, 4, v0
s_and_b32 s22, s3, 3
s_lshl_b32 s46, s22, 10
s_lshr_b32 s95, s21, 3
s_and_b32 s96, s21, 7
v_and_b32 v6, 1, v2
s_and_b32 s23, s22, 1
s_lshl_b32 s23, s23, 1
v_or_b32 v6, s23, v6
v_lshlrev_b32 v6, 1, v6
v_and_b32 v7, 7, v0
v_xor_b32 v6, v6, v7
v_lshrrev_b32 v5, 3, v0
s_lshl_b32 s23, s22, 3
v_add_u32 v5, s23, v5
s_cmp_ge_u32 s3, 4
s_cbranch_scc1 L_L
s_setprio 2
v_lshlrev_b32 v5, 13, v5
v_lshl_add_u32 v5, v6, 4, v5
s_lshl_b32 s23, s22, 1
v_add_u32 v4, s23, v2
v_lshlrev_b32 v3, 1, v4
v_xor_b32 v3, v3, v1
v_lshlrev_b32 v3, 4, v3
v_lshl_add_u32 v3, v4, 10, v3
s_lshl_b32 s43, s95, 20
s_lshl_b32 s44, s20, 10
s_add_u32 s43, s43, s44
s_lshl_b32 s44, s96, 7
s_add_u32 s43, s43, s44
s_lshl_b32 s45, s95, 8
s_add_u32 m0, s46, 131072
v_mov_b32 v144, 150784
v_mov_b32 v8, 0
v_mov_b32 v9, 0
v_mov_b32 v10, 0
v_mov_b32 v11, 0
s_mov_b64 exec, 1
ds_write_b128 v144, v[8:11]
ds_write_b128 v144, v[8:11] offset:16
s_mov_b64 exec, -1
v_mov_b32 v145, 1
s_waitcnt lgkmcnt(0)
s_mov_b32 s24, s10
s_mov_b32 s25, s11
s_mov_b32 s26, 0x400000
s_mov_b32 s27, 0x20000
buffer_load_dwordx4 v5, s[24:27], s43 offen nt lds
s_add_u32 m0, m0, 4096
s_add_u32 s43, s43, 0x40000
buffer_load_dwordx4 v5, s[24:27], s43 offen nt lds
s_add_u32 m0, m0, 4096
s_add_u32 s43, s43, 0x40000
buffer_load_dwordx4 v5, s[24:27], s43 offen nt lds
s_add_u32 m0, m0, 4096
s_add_u32 s43, s43, 0x40000
buffer_load_dwordx4 v5, s[24:27], s43 offen nt lds
s_mov_b32 s28, s4
s_mov_b32 s29, s5
s_mov_b32 s30, 0x2000
s_mov_b32 s31, 0x20000
s_lshl_b32 s23, s22, 9
s_add_u32 m0, s23, 147456
s_mov_b32 exec_hi, 0
buffer_load_dwordx4 v3, s[28:31], s45 offen lds
s_mov_b32 exec_hi, -1
s_barrier
s_load_dword s36, s[18:19], 0
s_mov_b32 s32, s18
s_mov_b32 s33, s19
s_mov_b32 s34, 0x490000
s_mov_b32 s35, 0x20000
v_bfe_u32 v6, v0, 2, 2
v_and_b32 v132, 3, v0
v_lshl_add_u32 v8, v2, 3, v6
v_and_b32 v9, 1, v2
v_lshl_or_b32 v10, v9, 2, v6
s_lshl_b32 s23, s22, 1
v_xor_b32 v10, s23, v10
v_lshlrev_b32 v4, 8, v8
v_lshl_add_u32 v4, v10, 5, v4
v_lshl_add_u32 v4, v132, 3, v4
v_add_u32 v4, 65536, v4
v_xor_b32 v5, 32, v4
v_lshrrev_b32 v10, 1, v6
v_lshl_or_b32 v10, v9, 1, v10
v_xor_b32 v10, s22, v10
v_lshlrev_b32 v6, 7, v8
v_lshl_add_u32 v6, v10, 5, v6
v_lshl_add_u32 v6, v132, 3, v6
v_add_u32 v6, 131072, v6
v_lshlrev_b32 v154, 13, v7
v_lshl_add_u32 v154, v2, 4, v154
s_lshl_b32 s47, s20, 16
s_add_u32 s47, s47, 65536
s_lshl_b32 s99, s95, 11
s_add_u32 s99, s99, s47
s_lshl_b32 s23, s96, 8
s_add_u32 s99, s99, s23
s_lshl_b32 s23, s22, 6
s_add_u32 s99, s99, s23
s_lshr_b32 s23, s21, 2
s_lshl_b32 s23, s23, 13
s_add_u32 s50, s47, s23
s_lshl_b32 s23, s22, 9
s_add_u32 s50, s50, s23
v_lshlrev_b32 v134, 1, v7
v_xor_b32 v134, v134, v2
v_lshlrev_b32 v134, 4, v134
v_lshl_add_u32 v134, v7, 8, v134
v_add_u32 v134, 147456, v134
v_xor_b32 v135, 64, v134
v_xor_b32 v136, 0x80, v134
v_xor_b32 v137, 0xc0, v134
v_mov_b32 v143, 0xfffffc00
s_mov_b32 s46, 0xff00ff
s_mov_b32 s47, 0xff00ff
s_waitcnt vmcnt(0)
s_mov_b64 exec, 1
ds_add_u32 v144, v145 offset:0
s_mov_b64 exec, -1
s_mov_b32 s42, 2097152
L_spinw:
ds_read_b32 v140, v144 offset:0
s_sub_u32 s42, s42, 1
s_cbranch_scc1 L_end
s_waitcnt lgkmcnt(0)
v_cmp_gt_u32 vcc, 4, v140
s_cbranch_vccz L_spinw_ok
s_sleep 1
s_branch L_spinw
L_spinw_ok:
ds_read_b128 v[16:19], v134
ds_read_b128 v[20:23], v135
ds_read_b128 v[24:27], v136
ds_read_b128 v[28:31], v137
ds_read_b64_tr_b16 v[48:49], v6 offset:0
ds_read_b64_tr_b16 v[50:51], v6 offset:512
ds_read_b64_tr_b16 v[52:53], v6 offset:4096
ds_read_b64_tr_b16 v[54:55], v6 offset:4608
ds_read_b64_tr_b16 v[56:57], v6 offset:8192
ds_read_b64_tr_b16 v[58:59], v6 offset:8704
ds_read_b64_tr_b16 v[60:61], v6 offset:12288
ds_read_b64_tr_b16 v[62:63], v6 offset:12800
s_add_u32 s36, s36, 1
s_and_b32 s37, s36, 0xff
s_or_b32 s37, s37, 0x100
s_bfe_u32 s38, s36, 0x80008
s_or_b32 s38, s38, 0x200
s_bfe_u32 s39, s36, 0x80010
s_or_b32 s39, s39, 0x300
s_lshr_b32 s40, s36, 24
s_xor_b32 s41, s36, 0x9e3779b9
s_getreg_b32 s23, hwreg(HW_REG_XCC_ID, 0, 4)
s_andn2_b32 s41, s41, 15
s_or_b32 s41, s41, s23
s_waitcnt lgkmcnt(0)
s_mov_b64 exec, 1
ds_add_u32 v144, v145 offset:20
s_mov_b64 exec, -1
v_mfma_f32_16x16x32_bf16 v[64:67], v[48:51], v[16:19], 0
v_mfma_f32_16x16x32_bf16 v[64:67], v[52:55], v[20:23], v[64:67]
v_mfma_f32_16x16x32_bf16 v[64:67], v[56:59], v[24:27], v[64:67]
v_mfma_f32_16x16x32_bf16 v[64:67], v[60:63], v[28:31], v[64:67]
v_lshrrev_b32 v134, 5, v0
v_and_b32 v135, 31, v0
v_lshlrev_b32 v3, 12, v134
v_lshl_add_u32 v3, v135, 4, v3
s_nop 3
v_add_u32 v64, 0x200, v64
v_add_u32 v65, 0x200, v65
v_add_u32 v66, 0x200, v66
v_add_u32 v67, 0x200, v67
v_bfi_b32 v146, v143, v64, s37
v_bfi_b32 v147, v143, v65, s38
v_bfi_b32 v148, v143, v66, s39
v_bfi_b32 v149, v143, v67, s40
s_mov_b64 exec, s[46:47]
buffer_store_dwordx4 v[146:149], v154, s[32:35], s99 offen
s_mov_b64 exec, -1
s_add_u32 s99, s99, 0x200000
v_lshl_add_u32 v155, v2, 3, v7
v_lshlrev_b32 v155, 4, v155
v_add_u32 v155, 155552, v155
s_lshl_b32 s23, s22, 9
v_add_u32 v140, s23, v155
s_mov_b64 exec, s[46:47]
ds_write_b128 v140, v[146:149] offset:2112
s_mov_b64 exec, -1
v_mul_u32_u24 v8, 576, v132
v_lshl_add_u32 v8, v2, 4, v8
v_add_u32 v8, 150944, v8
v_lshlrev_b32 v9, 4, v132
v_add_u32 v9, 150816, v9
v_lshlrev_b32 v10, 9, v132
v_bfe_u32 v11, v0, 2, 1
v_lshl_add_u32 v10, v11, 6, v10
v_lshl_add_u32 v10, v2, 4, v10
s_lshl_b32 s52, s20, 16
s_add_u32 s52, s52, 65536
s_lshl_b32 s53, s21, 11
s_add_u32 s53, s53, s52
s_lshl_b32 s23, s22, 7
s_add_u32 s53, s53, s23
s_lshl_b32 s54, s95, 9
s_add_u32 s54, s54, s52
s_lshl_b32 s23, s22, 14
s_add_u32 s54, s54, s23
s_add_u32 s97, s54, 4096
v_lshlrev_b32 v11, 13, v134
v_lshl_add_u32 v11, v135, 4, v11
v_lshlrev_b32 v12, 6, v134
v_lshl_add_u32 v12, v132, 4, v12
s_lshl_b32 s55, s20, 11
s_lshl_b32 s23, s95, 9
s_add_u32 s55, s55, s23
s_lshl_b32 s23, s22, 7
s_add_u32 s55, s55, s23
s_add_u32 s55, s55, 1114112
s_lshl_b32 s23, s22, 1
v_add_u32 v13, s23, v134
v_mul_u32_u24 v13, 288, v13
v_lshl_add_u32 v13, v135, 3, v13
v_add_u32 v13, 153248, v13
v_mul_u32_u24 v14, 288, v7
v_lshl_add_u32 v14, v2, 4, v14
v_add_u32 v14, 153248, v14
v_lshrrev_b32 v15, 1, v7
v_lshlrev_b32 v15, 17, v15
v_and_b32 v140, 1, v7
v_lshl_add_u32 v15, v140, 6, v15
v_lshl_add_u32 v15, v2, 4, v15
s_lshl2_add_u32 s56, s96, s22
s_lshl_b32 s56, s56, 12
s_lshl2_add_u32 s23, s20, s95
s_lshl_b32 s23, s23, 7
s_add_u32 s56, s56, s23
s_add_u32 s56, s56, 1179648
s_lshl_b32 s57, s20, 11
s_lshl_b32 s23, s22, 9
s_add_u32 s57, s57, s23
s_lshl_b32 s23, s21, 4
s_add_u32 s57, s57, s23
s_add_u32 s57, s57, 1114112
s_lshl_b64 s[58:59], 1, s22
s_mul_i32 s23, s22, 320
s_add_u32 s23, s23, 149504
v_lshlrev_b32 v136, 3, v135
v_lshl_add_u32 v136, v134, 1, v136
v_add_u32 v136, s23, v136
v_mul_u32_u24 v134, 320, v132
v_lshl_add_u32 v134, v2, 4, v134
v_add_u32 v134, 149504, v134
s_lshl_b32 s23, s22, 7
s_add_u32 s23, s23, 150944
v_lshl_add_u32 v135, v0, 1, s23
s_lshl_b32 s23, s22, 2
s_add_u32 s23, s23, 150816
v_mov_b32 v137, s23
v_xor_b32 v138, v1, v2
v_lshlrev_b32 v138, 4, v138
v_lshl_add_u32 v138, v1, 8, v138
s_lshl_b32 s23, s22, 14
v_add_u32 v138, s23, v138
v_xor_b32 v139, 64, v138
v_xor_b32 v141, 0x80, v138
v_xor_b32 v142, 0xc0, v138
s_lshl_b32 s100, s20, 11
s_lshl_b32 s23, s21, 6
s_add_u32 s100, s100, s23
s_lshl_b32 s23, s22, 4
s_add_u32 s100, s100, s23
s_add_u32 s100, s100, 1048576
s_andn2_b32 s98, s100, 0xf0
v_lshlrev_b32 v133, 4, v1
buffer_load_dword v192, v133, s[32:35], s98 offen sc1
buffer_load_dword v193, v12, s[32:35], s55 offen sc1
s_sleep 12
buffer_load_dwordx4 v[160:163], v3, s[32:35], s50 offen offset:0 sc1
buffer_load_dwordx4 v[164:167], v3, s[32:35], s50 offen offset:2048 sc1
s_sleep 16
buffer_load_dwordx4 v[168:171], v3, s[32:35], s50 offen offset:0 sc1
buffer_load_dwordx4 v[172:175], v3, s[32:35], s50 offen offset:2048 sc1
s_mov_b32 s42, 2097152
L_pollq:
s_waitcnt vmcnt(2)
v_xor_b32 v160, s37, v160
v_xor_b32 v161, s38, v161
v_xor_b32 v162, s39, v162
v_xor_b32 v163, s40, v163
v_or3_b32 v140, v160, v161, v162
v_or_b32 v140, v140, v163
v_xor_b32 v164, s37, v164
v_xor_b32 v165, s38, v165
v_xor_b32 v166, s39, v166
v_xor_b32 v167, s40, v167
v_or3_b32 v140, v140, v164, v165
v_or3_b32 v140, v140, v166, v167
v_and_b32 v140, 0x3ff, v140
v_cmp_ne_u32 vcc, 0, v140
s_cbranch_vccz L_pollq_ok0
buffer_load_dwordx4 v[160:163], v3, s[32:35], s50 offen offset:0 sc1
buffer_load_dwordx4 v[164:167], v3, s[32:35], s50 offen offset:2048 sc1
s_waitcnt vmcnt(2)
v_xor_b32 v168, s37, v168
v_xor_b32 v169, s38, v169
v_xor_b32 v170, s39, v170
v_xor_b32 v171, s40, v171
v_or3_b32 v140, v168, v169, v170
v_or_b32 v140, v140, v171
v_xor_b32 v172, s37, v172
v_xor_b32 v173, s38, v173
v_xor_b32 v174, s39, v174
v_xor_b32 v175, s40, v175
v_or3_b32 v140, v140, v172, v173
v_or3_b32 v140, v140, v174, v175
v_and_b32 v140, 0x3ff, v140
v_cmp_ne_u32 vcc, 0, v140
s_cbranch_vccz L_pollq_ok1
buffer_load_dwordx4 v[168:171], v3, s[32:35], s50 offen offset:0 sc1
buffer_load_dwordx4 v[172:175], v3, s[32:35], s50 offen offset:2048 sc1
s_cmp_lg_u32 s42, 2097148
s_cbranch_scc1 L_pollq_n
s_mov_b64 exec, s[46:47]
buffer_store_dwordx4 v[146:149], v154, s[32:35], s99 offen sc1
s_mov_b64 exec, -1
s_waitcnt vmcnt(0)
L_pollq_n:
s_min_u32 s23, s42, 2097128
s_bitcmp1_b32 s23, 0
s_cselect_b32 s23, 0x200000, 0
s_andn2_b32 s50, s50, 0x200000
s_or_b32 s50, s50, s23
s_sub_u32 s42, s42, 1
s_cbranch_scc0 L_pollq
s_endpgm
L_pollq_ok1:
v_add_f32 v16, v168, v172
v_add_f32 v17, v169, v173
v_add_f32 v18, v170, v174
v_add_f32 v19, v171, v175
s_branch L_pollq_done
L_pollq_ok0:
v_add_f32 v16, v160, v164
v_add_f32 v17, v161, v165
v_add_f32 v18, v162, v166
v_add_f32 v19, v163, v167
L_pollq_done:
s_nop 1
v_permlane32_swap_b32 v16, v17
v_permlane32_swap_b32 v18, v19
v_add_f32 v16, v16, v17
v_add_f32 v18, v18, v19
v_cvt_pk_bf16_f32 v16, v16, v18
ds_write_b16 v136, v16
ds_write_b16_d16_hi v136, v16 offset:4
s_mov_b64 exec, 1
ds_add_u32 v144, v145 offset:4
s_mov_b64 exec, -1
v_mov_b32 v3, 0
v_mov_b32 v150, 0
v_mov_b32 v151, 0
v_mov_b32 v152, s36
v_mov_b32 v153, s41
s_mov_b64 exec, 1
buffer_store_dwordx4 v[150:153], v3, s[32:35], s100 offen
s_mov_b64 exec, -1
s_xor_b32 s37, s37, 0x300
s_xor_b32 s38, s38, 0x100
s_xor_b32 s39, s39, 0x300
s_xor_b32 s40, s40, 0x100
s_mov_b32 s44, 0xffff0000
s_mov_b32 s45, 0x0
s_mov_b32 s48, 0x0
s_mov_b32 s49, 0xffff
s_mov_b32 s50, 0x0
s_mov_b32 s51, 0xffff0000
s_mov_b32 s42, 2097152
L_spinq:
s_cmp_lg_u32 s42, 2096992
s_cbranch_scc1 L_spinq_n
s_mov_b64 exec, s[46:47]
buffer_store_dwordx4 v[146:149], v154, s[32:35], s99 offen sc1
s_mov_b64 exec, -1
L_spinq_n:
ds_read_b32 v140, v144 offset:4
s_sub_u32 s42, s42, 1
s_cbranch_scc1 L_end
s_waitcnt lgkmcnt(0)
v_cmp_gt_u32 vcc, 8, v140
s_cbranch_vccz L_spinq_ok
s_sleep 1
s_branch L_spinq
L_spinq_ok:
buffer_load_dwordx4 v[188:191], v133, s[32:35], s98 offen sc1
ds_read_b128 v[80:83], v134 offset:0
ds_read_b128 v[84:87], v134 offset:64
ds_read_b128 v[88:91], v134 offset:128
ds_read_b128 v[92:95], v134 offset:192
ds_read_b128 v[16:19], v138 offset:0
ds_read_b128 v[20:23], v139 offset:0
ds_read_b128 v[24:27], v141 offset:0
ds_read_b128 v[28:31], v142 offset:0
ds_read_b128 v[32:35], v138 offset:4096
ds_read_b128 v[36:39], v139 offset:4096
ds_read_b128 v[40:43], v141 offset:4096
ds_read_b128 v[44:47], v142 offset:4096
ds_read_b128 v[48:51], v138 offset:8192
ds_read_b128 v[52:55], v139 offset:8192
ds_read_b128 v[56:59], v141 offset:8192
ds_read_b128 v[60:63], v142 offset:8192
ds_read_b128 v[64:67], v138 offset:12288
ds_read_b128 v[68:71], v139 offset:12288
ds_read_b128 v[72:75], v141 offset:12288
ds_read_b128 v[76:79], v142 offset:12288
s_waitcnt lgkmcnt(12)
v_mfma_f32_16x16x32_bf16 v[96:99], v[80:83], v[16:19], 0
v_mfma_f32_16x16x32_bf16 v[96:99], v[84:87], v[20:23], v[96:99]
v_mfma_f32_16x16x32_bf16 v[96:99], v[88:91], v[24:27], v[96:99]
v_mfma_f32_16x16x32_bf16 v[96:99], v[92:95], v[28:31], v[96:99]
s_waitcnt lgkmcnt(8)
v_mfma_f32_16x16x32_bf16 v[100:103], v[80:83], v[32:35], 0
v_mfma_f32_16x16x32_bf16 v[100:103], v[84:87], v[36:39], v[100:103]
v_mfma_f32_16x16x32_bf16 v[100:103], v[88:91], v[40:43], v[100:103]
v_mfma_f32_16x16x32_bf16 v[100:103], v[92:95], v[44:47], v[100:103]
s_waitcnt lgkmcnt(4)
v_mfma_f32_16x16x32_bf16 v[104:107], v[80:83], v[48:51], 0
v_mfma_f32_16x16x32_bf16 v[104:107], v[84:87], v[52:55], v[104:107]
v_mfma_f32_16x16x32_bf16 v[104:107], v[88:91], v[56:59], v[104:107]
v_mfma_f32_16x16x32_bf16 v[104:107], v[92:95], v[60:63], v[104:107]
s_waitcnt lgkmcnt(0)
v_mfma_f32_16x16x32_bf16 v[108:111], v[80:83], v[64:67], 0
v_mfma_f32_16x16x32_bf16 v[108:111], v[84:87], v[68:71], v[108:111]
v_mfma_f32_16x16x32_bf16 v[108:111], v[88:91], v[72:75], v[108:111]
v_mfma_f32_16x16x32_bf16 v[108:111], v[92:95], v[76:79], v[108:111]
s_nop 7
v_cndmask_b32 v96, v96, v100, s[44:45]
v_cndmask_b32 v97, v97, v101, s[44:45]
v_cndmask_b32 v98, v98, v102, s[44:45]
v_cndmask_b32 v99, v99, v103, s[44:45]
v_cndmask_b32 v96, v96, v104, s[48:49]
v_cndmask_b32 v97, v97, v105, s[48:49]
v_cndmask_b32 v98, v98, v106, s[48:49]
v_cndmask_b32 v99, v99, v107, s[48:49]
v_cndmask_b32 v96, v96, v108, s[50:51]
v_cndmask_b32 v97, v97, v109, s[50:51]
v_cndmask_b32 v98, v98, v110, s[50:51]
v_cndmask_b32 v99, v99, v111, s[50:51]
v_cvt_pk_bf16_f32 v140, v96, v97
v_cvt_pk_bf16_f32 v141, v98, v99
v_lshlrev_b32 v96, 16, v140
v_and_b32 v97, 0xffff0000, v140
v_lshlrev_b32 v98, 16, v141
v_and_b32 v99, 0xffff0000, v141
v_mul_f32 v96, 0x3db504f3, v96
v_mul_f32 v97, 0x3db504f3, v97
v_mul_f32 v98, 0x3db504f3, v98
v_mul_f32 v99, 0x3db504f3, v99
v_cvt_pk_bf16_f32 v140, v96, v97
v_cvt_pk_bf16_f32 v141, v98, v99
v_lshlrev_b32 v96, 16, v140
v_and_b32 v97, 0xffff0000, v140
v_lshlrev_b32 v98, 16, v141
v_and_b32 v99, 0xffff0000, v141
v_mul_f32 v96, 0x3fb8aa3b, v96
v_mul_f32 v97, 0x3fb8aa3b, v97
v_mul_f32 v98, 0x3fb8aa3b, v98
v_mul_f32 v99, 0x3fb8aa3b, v99
v_mov_b32 v100, v96
v_mov_b32 v101, v97
v_mov_b32 v102, v98
v_mov_b32 v103, v99
v_max_f32_dpp v100, v100, v100 row_shr:1 row_mask:0xf bank_mask:0xf
v_max_f32_dpp v101, v101, v101 row_shr:1 row_mask:0xf bank_mask:0xf
v_max_f32_dpp v102, v102, v102 row_shr:1 row_mask:0xf bank_mask:0xf
v_max_f32_dpp v103, v103, v103 row_shr:1 row_mask:0xf bank_mask:0xf
v_max_f32_dpp v100, v100, v100 row_shr:2 row_mask:0xf bank_mask:0xf
v_max_f32_dpp v101, v101, v101 row_shr:2 row_mask:0xf bank_mask:0xf
v_max_f32_dpp v102, v102, v102 row_shr:2 row_mask:0xf bank_mask:0xf
v_max_f32_dpp v103, v103, v103 row_shr:2 row_mask:0xf bank_mask:0xf
v_max_f32_dpp v100, v100, v100 row_shr:4 row_mask:0xf bank_mask:0xf
v_max_f32_dpp v101, v101, v101 row_shr:4 row_mask:0xf bank_mask:0xf
v_max_f32_dpp v102, v102, v102 row_shr:4 row_mask:0xf bank_mask:0xf
v_max_f32_dpp v103, v103, v103 row_shr:4 row_mask:0xf bank_mask:0xf
v_max_f32_dpp v100, v100, v100 row_shr:8 row_mask:0xf bank_mask:0xf
v_max_f32_dpp v101, v101, v101 row_shr:8 row_mask:0xf bank_mask:0xf
v_max_f32_dpp v102, v102, v102 row_shr:8 row_mask:0xf bank_mask:0xf
v_max_f32_dpp v103, v103, v103 row_shr:8 row_mask:0xf bank_mask:0xf
v_max_f32_dpp v100, v100, v100 row_bcast:15 row_mask:0xa bank_mask:0xf
v_max_f32_dpp v101, v101, v101 row_bcast:15 row_mask:0xa bank_mask:0xf
v_max_f32_dpp v102, v102, v102 row_bcast:15 row_mask:0xa bank_mask:0xf
v_max_f32_dpp v103, v103, v103 row_bcast:15 row_mask:0xa bank_mask:0xf
v_max_f32_dpp v100, v100, v100 row_bcast:31 row_mask:0xc bank_mask:0xf
v_max_f32_dpp v101, v101, v101 row_bcast:31 row_mask:0xc bank_mask:0xf
v_max_f32_dpp v102, v102, v102 row_bcast:31 row_mask:0xc bank_mask:0xf
v_max_f32_dpp v103, v103, v103 row_bcast:31 row_mask:0xc bank_mask:0xf
s_mov_b32 exec_lo, 0
s_mov_b32 exec_hi, 0x80000000
ds_write_b32 v137, v100 offset:0
ds_write_b32 v137, v101 offset:16
ds_write_b32 v137, v102 offset:32
ds_write_b32 v137, v103 offset:48
ds_add_u32 v144, v145 offset:16
s_mov_b64 exec, -1
v_mov_b32 v138, 150816
s_mov_b32 s42, 2097152
L_spinm:
ds_read_b32 v140, v144 offset:16
s_sub_u32 s42, s42, 1
s_cbranch_scc1 L_end
s_waitcnt lgkmcnt(0)
v_cmp_gt_u32 vcc, 4, v140
s_cbranch_vccz L_spinm_ok
s_sleep 1
s_branch L_spinm
L_spinm_ok:
ds_read_b128 v[104:107], v138 offset:0
ds_read_b128 v[108:111], v138 offset:16
ds_read_b128 v[112:115], v138 offset:32
ds_read_b128 v[116:119], v138 offset:48
s_waitcnt lgkmcnt(0)
v_max3_f32 v100, v104, v105, v106
v_max3_f32 v101, v108, v109, v110
v_max3_f32 v102, v112, v113, v114
v_max3_f32 v103, v116, v117, v118
v_max_f32 v100, v100, v107
v_max_f32 v101, v101, v111
v_max_f32 v102, v102, v115
v_max_f32 v103, v103, v119
v_sub_f32 v96, v96, v100
v_sub_f32 v97, v97, v101
v_sub_f32 v98, v98, v102
v_sub_f32 v99, v99, v103
v_exp_f32 v96, v96
v_exp_f32 v97, v97
v_exp_f32 v98, v98
v_exp_f32 v99, v99
s_nop 0
v_cvt_pk_bf16_f32 v140, v96, v97
v_cvt_pk_bf16_f32 v141, v98, v99
ds_write_b16 v135, v140
ds_write_b16_d16_hi v135, v140 offset:576
ds_write_b16 v135, v141 offset:1152
ds_write_b16_d16_hi v135, v141 offset:1728
v_add_f32_dpp v96, v96, v96 row_shr:1 row_mask:0xf bank_mask:0xf
v_add_f32_dpp v97, v97, v97 row_shr:1 row_mask:0xf bank_mask:0xf
v_add_f32_dpp v98, v98, v98 row_shr:1 row_mask:0xf bank_mask:0xf
v_add_f32_dpp v99, v99, v99 row_shr:1 row_mask:0xf bank_mask:0xf
v_add_f32_dpp v96, v96, v96 row_shr:2 row_mask:0xf bank_mask:0xf
v_add_f32_dpp v97, v97, v97 row_shr:2 row_mask:0xf bank_mask:0xf
v_add_f32_dpp v98, v98, v98 row_shr:2 row_mask:0xf bank_mask:0xf
v_add_f32_dpp v99, v99, v99 row_shr:2 row_mask:0xf bank_mask:0xf
v_add_f32_dpp v96, v96, v96 row_shr:4 row_mask:0xf bank_mask:0xf
v_add_f32_dpp v97, v97, v97 row_shr:4 row_mask:0xf bank_mask:0xf
v_add_f32_dpp v98, v98, v98 row_shr:4 row_mask:0xf bank_mask:0xf
v_add_f32_dpp v99, v99, v99 row_shr:4 row_mask:0xf bank_mask:0xf
v_add_f32_dpp v96, v96, v96 row_shr:8 row_mask:0xf bank_mask:0xf
v_add_f32_dpp v97, v97, v97 row_shr:8 row_mask:0xf bank_mask:0xf
v_add_f32_dpp v98, v98, v98 row_shr:8 row_mask:0xf bank_mask:0xf
v_add_f32_dpp v99, v99, v99 row_shr:8 row_mask:0xf bank_mask:0xf
v_add_f32_dpp v96, v96, v96 row_bcast:15 row_mask:0xa bank_mask:0xf
v_add_f32_dpp v97, v97, v97 row_bcast:15 row_mask:0xa bank_mask:0xf
v_add_f32_dpp v98, v98, v98 row_bcast:15 row_mask:0xa bank_mask:0xf
v_add_f32_dpp v99, v99, v99 row_bcast:15 row_mask:0xa bank_mask:0xf
v_add_f32_dpp v96, v96, v96 row_bcast:31 row_mask:0xc bank_mask:0xf
v_add_f32_dpp v97, v97, v97 row_bcast:31 row_mask:0xc bank_mask:0xf
v_add_f32_dpp v98, v98, v98 row_bcast:31 row_mask:0xc bank_mask:0xf
v_add_f32_dpp v99, v99, v99 row_bcast:31 row_mask:0xc bank_mask:0xf
s_mov_b32 exec_lo, 0
s_mov_b32 exec_hi, 0x80000000
ds_write_b32 v137, v96 offset:64
ds_write_b32 v137, v97 offset:80
ds_write_b32 v137, v98 offset:96
ds_write_b32 v137, v99 offset:112
ds_add_u32 v144, v145 offset:16
s_mov_b64 exec, -1
s_mov_b32 s44, 0xf0f0f0f0
s_mov_b32 s45, 0xf0f0f0f0
s_mov_b32 s42, 2097152
L_spinl:
ds_read_b32 v142, v144 offset:16
s_sub_u32 s42, s42, 1
s_cbranch_scc1 L_end
s_waitcnt lgkmcnt(0)
v_cmp_gt_u32 vcc, 8, v142
s_cbranch_vccz L_spinl_ok
s_sleep 1
s_branch L_spinl
L_spinl_ok:
buffer_load_dwordx4 v[196:199], v133, s[32:35], s98 offen sc1
ds_read_b128 v[128:131], v9
ds_read_b128 v[120:123], v9 offset:64
ds_read_b128 v[16:19], v8 offset:0
ds_read_b128 v[20:23], v8 offset:64
ds_read_b128 v[24:27], v8 offset:128
ds_read_b128 v[28:31], v8 offset:192
ds_read_b128 v[32:35], v8 offset:256
ds_read_b128 v[36:39], v8 offset:320
ds_read_b128 v[40:43], v8 offset:384
ds_read_b128 v[44:47], v8 offset:448
s_waitcnt lgkmcnt(8)
v_max3_f32 v150, v128, v129, v130
v_max_f32 v150, v150, v131
v_add_f32 v128, v120, v121
v_add_f32 v130, v122, v123
v_add_f32 v151, v128, v130
s_mov_b64 exec, s[58:59]
buffer_store_dwordx4 v[150:153], v3, s[32:35], s57 offen
s_mov_b64 exec, -1
s_mov_b32 s42, 2097152
L_spin1:
ds_read_b32 v141, v144 offset:8
s_sub_u32 s42, s42, 1
s_cbranch_scc1 L_end
s_waitcnt lgkmcnt(0)
v_cmp_gt_u32 vcc, 4, v141
s_cbranch_vccz L_spin1_ok
s_sleep 1
s_branch L_spin1
L_spin1_ok:
ds_read_b64_tr_b16 v[48:49], v4 offset:0
ds_read_b64_tr_b16 v[50:51], v4 offset:1024
ds_read_b64_tr_b16 v[52:53], v5 offset:0
ds_read_b64_tr_b16 v[54:55], v5 offset:1024
ds_read_b64_tr_b16 v[56:57], v4 offset:8192
ds_read_b64_tr_b16 v[58:59], v4 offset:9216
ds_read_b64_tr_b16 v[60:61], v5 offset:8192
ds_read_b64_tr_b16 v[62:63], v5 offset:9216
ds_read_b64_tr_b16 v[64:65], v4 offset:16384
ds_read_b64_tr_b16 v[66:67], v4 offset:17408
ds_read_b64_tr_b16 v[68:69], v5 offset:16384
ds_read_b64_tr_b16 v[70:71], v5 offset:17408
ds_read_b64_tr_b16 v[72:73], v4 offset:24576
ds_read_b64_tr_b16 v[74:75], v4 offset:25600
ds_read_b64_tr_b16 v[76:77], v5 offset:24576
ds_read_b64_tr_b16 v[78:79], v5 offset:25600
s_waitcnt lgkmcnt(0)
v_mfma_f32_16x16x32_bf16 v[96:99], v[48:51], v[16:19], 0
v_mfma_f32_16x16x32_bf16 v[100:103], v[52:55], v[16:19], 0
v_mfma_f32_16x16x32_bf16 v[96:99], v[56:59], v[20:23], v[96:99]
v_mfma_f32_16x16x32_bf16 v[100:103], v[60:63], v[20:23], v[100:103]
v_mfma_f32_16x16x32_bf16 v[96:99], v[64:67], v[24:27], v[96:99]
v_mfma_f32_16x16x32_bf16 v[100:103], v[68:71], v[24:27], v[100:103]
v_mfma_f32_16x16x32_bf16 v[96:99], v[72:75], v[28:31], v[96:99]
v_mfma_f32_16x16x32_bf16 v[100:103], v[76:79], v[28:31], v[100:103]
s_mov_b32 s42, 2097152
L_spin2:
ds_read_b32 v141, v144 offset:12
s_sub_u32 s42, s42, 1
s_cbranch_scc1 L_end
s_waitcnt lgkmcnt(0)
v_cmp_gt_u32 vcc, 4, v141
s_cbranch_vccz L_spin2_ok
s_sleep 1
s_branch L_spin2
L_spin2_ok:
buffer_load_dwordx4 v[104:107], v12, s[32:35], s55 offen sc1
ds_read_b64_tr_b16 v[80:81], v4 offset:32768
ds_read_b64_tr_b16 v[82:83], v4 offset:33792
ds_read_b64_tr_b16 v[84:85], v5 offset:32768
ds_read_b64_tr_b16 v[86:87], v5 offset:33792
ds_read_b64_tr_b16 v[88:89], v4 offset:40960
ds_read_b64_tr_b16 v[90:91], v4 offset:41984
ds_read_b64_tr_b16 v[92:93], v5 offset:40960
ds_read_b64_tr_b16 v[94:95], v5 offset:41984
s_waitcnt lgkmcnt(0)
v_mfma_f32_16x16x32_bf16 v[96:99], v[80:83], v[32:35], v[96:99]
v_mfma_f32_16x16x32_bf16 v[100:103], v[84:87], v[32:35], v[100:103]
v_mfma_f32_16x16x32_bf16 v[96:99], v[88:91], v[36:39], v[96:99]
v_mfma_f32_16x16x32_bf16 v[100:103], v[92:95], v[36:39], v[100:103]
s_waitcnt vmcnt(3)
v_xor_b32 v190, s36, v190
v_xor_b32 v191, s41, v191
v_and_or_b32 v190, v191, -16, v190
v_cmp_ne_u32 vcc, 0, v190
s_cbranch_vccz L_sib_ok
s_mov_b32 s42, 2097152
s_waitcnt vmcnt(2)
s_branch L_sib_w
L_sib:
s_cmp_lg_u32 s42, 2097144
s_cbranch_scc1 L_sib_n
s_mov_b64 exec, s[46:47]
buffer_store_dwordx4 v[146:149], v154, s[32:35], s99 offen sc1
s_mov_b64 exec, -1
s_mov_b64 exec, 1
buffer_store_dwordx4 v[150:153], v3, s[32:35], s100 offen sc1
s_mov_b64 exec, -1
L_sib_n:
buffer_load_dwordx4 v[196:199], v133, s[32:35], s98 offen sc1
s_waitcnt vmcnt(0)
L_sib_w:
v_xor_b32 v198, s36, v198
v_xor_b32 v199, s41, v199
v_and_or_b32 v198, v199, -16, v198
v_cmp_ne_u32 vcc, 0, v198
s_sub_u32 s42, s42, 1
s_cbranch_scc1 L_end
s_cbranch_vccnz L_sib
L_sib_ok:
s_barrier
ds_read_b64_tr_b16 v[48:49], v4 offset:49152
ds_read_b64_tr_b16 v[50:51], v4 offset:50176
ds_read_b64_tr_b16 v[52:53], v5 offset:49152
ds_read_b64_tr_b16 v[54:55], v5 offset:50176
ds_read_b64_tr_b16 v[56:57], v4 offset:57344
ds_read_b64_tr_b16 v[58:59], v4 offset:58368
ds_read_b64_tr_b16 v[60:61], v5 offset:57344
ds_read_b64_tr_b16 v[62:63], v5 offset:58368
s_waitcnt lgkmcnt(4)
v_mfma_f32_16x16x32_bf16 v[96:99], v[48:51], v[40:43], v[96:99]
v_mfma_f32_16x16x32_bf16 v[100:103], v[52:55], v[40:43], v[100:103]
s_waitcnt lgkmcnt(0)
v_mfma_f32_16x16x32_bf16 v[96:99], v[56:59], v[44:47], v[96:99]
v_mfma_f32_16x16x32_bf16 v[100:103], v[60:63], v[44:47], v[100:103]
s_nop 7
v_cndmask_b32 v96, v96, v100, s[44:45]
v_cndmask_b32 v97, v97, v101, s[44:45]
v_cndmask_b32 v98, v98, v102, s[44:45]
v_cndmask_b32 v99, v99, v103, s[44:45]
v_bfi_b32 v136, v143, v96, s37
v_bfi_b32 v137, v143, v97, s38
v_bfi_b32 v138, v143, v98, s39
v_bfi_b32 v139, v143, v99, s40
s_mov_b64 exec, s[46:47]
buffer_store_dwordx4 v[136:139], v10, s[32:35], s53 offen
s_mov_b64 exec, -1
buffer_load_dwordx4 v[24:27], v11, s[32:35], s54 offen offset:0 sc1
buffer_load_dwordx4 v[28:31], v11, s[32:35], s54 offen offset:2048 sc1
buffer_load_dwordx4 v[32:35], v11, s[32:35], s97 offen offset:0 sc1
buffer_load_dwordx4 v[36:39], v11, s[32:35], s97 offen offset:2048 sc1
s_lshl_b32 s23, s22, 9
v_add_u32 v142, s23, v155
s_mov_b64 exec, s[46:47]
ds_write_b128 v142, v[136:139]
s_mov_b64 exec, s[58:59]
v_lshlrev_b32 v88, 4, v0
v_add_u32 v88, 157600, v88
ds_write_b128 v88, v[150:153]
ds_add_u32 v144, v145 offset:24
s_mov_b64 exec, -1
s_mov_b32 s42, 2097152
s_waitcnt vmcnt(5)
s_branch L_polls_w
L_polls:
s_cmp_lg_u32 s42, 2097144
s_cbranch_scc1 L_polls_n
s_waitcnt vmcnt(0)
s_mov_b32 s43, 2097152
L_thru1:
ds_read_b32 v160, v144 offset:24
s_sub_u32 s43, s43, 1
s_cbranch_scc1 L_end
s_waitcnt lgkmcnt(0)
v_cmp_gt_u32 vcc, 4, v160
s_cbranch_vccz L_thru1_ok
s_sleep 1
s_branch L_thru1
L_thru1_ok:
s_lshl_b32 s23, s22, 7
s_sub_u32 s94, s53, s23
s_add_u32 s94, s94, 0x400000
s_lshl_b32 s23, s22, 9
s_sub_u32 s95, s57, s23
s_lshl_b32 s23, s22, 6
s_sub_u32 s96, s99, s23
s_mov_b64 exec, s[46:47]
ds_read_b128 v[160:163], v155 offset:0
ds_read_b128 v[176:179], v155 offset:2112
ds_read_b128 v[164:167], v155 offset:512
ds_read_b128 v[180:183], v155 offset:2624
ds_read_b128 v[168:171], v155 offset:1024
ds_read_b128 v[184:187], v155 offset:3136
ds_read_b128 v[172:175], v155 offset:1536
ds_read_b128 v[188:191], v155 offset:3648
s_waitcnt lgkmcnt(0)
buffer_store_dwordx4 v[176:179], v154, s[32:35], s96 offen offset:0 sc1
buffer_store_dwordx4 v[160:163], v10, s[32:35], s94 offen offset:0 sc1
buffer_store_dwordx4 v[180:183], v154, s[32:35], s96 offen offset:64 sc1
buffer_store_dwordx4 v[164:167], v10, s[32:35], s94 offen offset:128 sc1
buffer_store_dwordx4 v[184:187], v154, s[32:35], s96 offen offset:128 sc1
buffer_store_dwordx4 v[168:171], v10, s[32:35], s94 offen offset:256 sc1
buffer_store_dwordx4 v[188:191], v154, s[32:35], s96 offen offset:192 sc1
buffer_store_dwordx4 v[172:175], v10, s[32:35], s94 offen offset:384 sc1
s_mov_b64 exec, 15
v_lshlrev_b32 v192, 4, v0
v_add_u32 v192, 157600, v192
ds_read_b128 v[196:199], v192
v_lshlrev_b32 v193, 9, v0
s_waitcnt lgkmcnt(0)
v_lshlrev_b32 v194, 4, v0
s_andn2_b32 s94, s100, 0x30
buffer_store_dwordx4 v[196:199], v194, s[32:35], s94 offen sc1
buffer_store_dwordx4 v[196:199], v193, s[32:35], s95 offen sc1
s_mov_b64 exec, -1
s_waitcnt vmcnt(0)
L_polls_n:
buffer_load_dwordx4 v[104:107], v12, s[32:35], s55 offen sc1
s_waitcnt vmcnt(0)
L_polls_w:
v_xor_b32 v106, s36, v106
v_xor_b32 v107, s41, v107
v_and_or_b32 v106, v107, -16, v106
v_cmp_ne_u32 vcc, 0, v106
s_sub_u32 s42, s42, 1
s_cbranch_scc1 L_end
s_cbranch_vccnz L_polls
v_cmp_ne_u32 vcc, 0, v107
s_cbranch_vccz L_local
s_waitcnt vmcnt(0)
s_mov_b32 s43, 2097152
L_thru2:
ds_read_b32 v160, v144 offset:24
s_sub_u32 s43, s43, 1
s_cbranch_scc1 L_end
s_waitcnt lgkmcnt(0)
v_cmp_gt_u32 vcc, 4, v160
s_cbranch_vccz L_thru2_ok
s_sleep 1
s_branch L_thru2
L_thru2_ok:
s_lshl_b32 s23, s22, 7
s_sub_u32 s94, s53, s23
s_add_u32 s94, s94, 0x400000
s_lshl_b32 s23, s22, 9
s_sub_u32 s95, s57, s23
s_lshl_b32 s23, s22, 6
s_sub_u32 s96, s99, s23
s_mov_b64 exec, s[46:47]
ds_read_b128 v[160:163], v155 offset:0
ds_read_b128 v[176:179], v155 offset:2112
ds_read_b128 v[164:167], v155 offset:512
ds_read_b128 v[180:183], v155 offset:2624
ds_read_b128 v[168:171], v155 offset:1024
ds_read_b128 v[184:187], v155 offset:3136
ds_read_b128 v[172:175], v155 offset:1536
ds_read_b128 v[188:191], v155 offset:3648
s_waitcnt lgkmcnt(0)
buffer_store_dwordx4 v[176:179], v154, s[32:35], s96 offen offset:0 sc1
buffer_store_dwordx4 v[160:163], v10, s[32:35], s94 offen offset:0 sc1
buffer_store_dwordx4 v[180:183], v154, s[32:35], s96 offen offset:64 sc1
buffer_store_dwordx4 v[164:167], v10, s[32:35], s94 offen offset:128 sc1
buffer_store_dwordx4 v[184:187], v154, s[32:35], s96 offen offset:128 sc1
buffer_store_dwordx4 v[168:171], v10, s[32:35], s94 offen offset:256 sc1
buffer_store_dwordx4 v[188:191], v154, s[32:35], s96 offen offset:192 sc1
buffer_store_dwordx4 v[172:175], v10, s[32:35], s94 offen offset:384 sc1
s_mov_b64 exec, 15
v_lshlrev_b32 v192, 4, v0
v_add_u32 v192, 157600, v192
ds_read_b128 v[196:199], v192
v_lshlrev_b32 v193, 9, v0
s_waitcnt lgkmcnt(0)
v_lshlrev_b32 v194, 4, v0
s_andn2_b32 s94, s100, 0x30
buffer_store_dwordx4 v[196:199], v194, s[32:35], s94 offen sc1
buffer_store_dwordx4 v[196:199], v193, s[32:35], s95 offen sc1
s_mov_b64 exec, -1
s_waitcnt vmcnt(0)
L_local:
v_mov_b32 v108, v104
s_nop 1
v_max_f32_dpp v108, v108, v108 quad_perm:[1,0,3,2] row_mask:0xf bank_mask:0xf
s_nop 1
v_max_f32_dpp v108, v108, v108 quad_perm:[2,3,0,1] row_mask:0xf bank_mask:0xf
v_sub_f32 v104, v104, v108
v_exp_f32 v104, v104
s_nop 0
v_mul_f32 v105, v104, v105
s_nop 1
v_add_f32_dpp v105, v105, v105 quad_perm:[1,0,3,2] row_mask:0xf bank_mask:0xf
s_nop 1
v_add_f32_dpp v105, v105, v105 quad_perm:[2,3,0,1] row_mask:0xf bank_mask:0xf
v_rcp_f32 v105, v105
s_nop 0
v_mul_f32 v104, v104, v105
s_nop 1
v_mov_b32_dpp v108, v104 quad_perm:[0,0,0,0] row_mask:0xf bank_mask:0xf
v_mov_b32_dpp v109, v104 quad_perm:[1,1,1,1] row_mask:0xf bank_mask:0xf
v_mov_b32_dpp v110, v104 quad_perm:[2,2,2,2] row_mask:0xf bank_mask:0xf
v_mov_b32_dpp v111, v104 quad_perm:[3,3,3,3] row_mask:0xf bank_mask:0xf
buffer_load_dwordx4 v[40:43], v11, s[32:35], s54 offen offset:0 sc1
buffer_load_dwordx4 v[44:47], v11, s[32:35], s54 offen offset:2048 sc1
buffer_load_dwordx4 v[48:51], v11, s[32:35], s97 offen offset:0 sc1
buffer_load_dwordx4 v[52:55], v11, s[32:35], s97 offen offset:2048 sc1
s_mov_b32 s42, 2097152
L_pollo:
s_waitcnt vmcnt(4)
v_xor_b32 v24, s37, v24
v_xor_b32 v25, s38, v25
v_xor_b32 v26, s39, v26
v_xor_b32 v27, s40, v27
v_or3_b32 v140, v24, v25, v26
v_or_b32 v140, v140, v27
v_xor_b32 v28, s37, v28
v_xor_b32 v29, s38, v29
v_xor_b32 v30, s39, v30
v_xor_b32 v31, s40, v31
v_or3_b32 v140, v140, v28, v29
v_or3_b32 v140, v140, v30, v31
v_xor_b32 v32, s37, v32
v_xor_b32 v33, s38, v33
v_xor_b32 v34, s39, v34
v_xor_b32 v35, s40, v35
v_or3_b32 v140, v140, v32, v33
v_or3_b32 v140, v140, v34, v35
v_xor_b32 v36, s37, v36
v_xor_b32 v37, s38, v37
v_xor_b32 v38, s39, v38
v_xor_b32 v39, s40, v39
v_or3_b32 v140, v140, v36, v37
v_or3_b32 v140, v140, v38, v39
v_and_b32 v140, 0x3ff, v140
v_cmp_ne_u32 vcc, 0, v140
s_cbranch_vccz L_pollo_ok0
buffer_load_dwordx4 v[24:27], v11, s[32:35], s54 offen offset:0 sc1
buffer_load_dwordx4 v[28:31], v11, s[32:35], s54 offen offset:2048 sc1
buffer_load_dwordx4 v[32:35], v11, s[32:35], s97 offen offset:0 sc1
buffer_load_dwordx4 v[36:39], v11, s[32:35], s97 offen offset:2048 sc1
s_waitcnt vmcnt(4)
v_xor_b32 v40, s37, v40
v_xor_b32 v41, s38, v41
v_xor_b32 v42, s39, v42
v_xor_b32 v43, s40, v43
v_or3_b32 v140, v40, v41, v42
v_or_b32 v140, v140, v43
v_xor_b32 v44, s37, v44
v_xor_b32 v45, s38, v45
v_xor_b32 v46, s39, v46
v_xor_b32 v47, s40, v47
v_or3_b32 v140, v140, v44, v45
v_or3_b32 v140, v140, v46, v47
v_xor_b32 v48, s37, v48
v_xor_b32 v49, s38, v49
v_xor_b32 v50, s39, v50
v_xor_b32 v51, s40, v51
v_or3_b32 v140, v140, v48, v49
v_or3_b32 v140, v140, v50, v51
v_xor_b32 v52, s37, v52
v_xor_b32 v53, s38, v53
v_xor_b32 v54, s39, v54
v_xor_b32 v55, s40, v55
v_or3_b32 v140, v140, v52, v53
v_or3_b32 v140, v140, v54, v55
v_and_b32 v140, 0x3ff, v140
v_cmp_ne_u32 vcc, 0, v140
s_cbranch_vccz L_pollo_ok1
buffer_load_dwordx4 v[40:43], v11, s[32:35], s54 offen offset:0 sc1
buffer_load_dwordx4 v[44:47], v11, s[32:35], s54 offen offset:2048 sc1
buffer_load_dwordx4 v[48:51], v11, s[32:35], s97 offen offset:0 sc1
buffer_load_dwordx4 v[52:55], v11, s[32:35], s97 offen offset:2048 sc1
s_cmp_lg_u32 s42, 2097144
s_cbranch_scc1 L_pollo_n
s_waitcnt vmcnt(0)
s_mov_b32 s43, 2097152
L_thru3:
ds_read_b32 v160, v144 offset:24
s_sub_u32 s43, s43, 1
s_cbranch_scc1 L_end
s_waitcnt lgkmcnt(0)
v_cmp_gt_u32 vcc, 4, v160
s_cbranch_vccz L_thru3_ok
s_sleep 1
s_branch L_thru3
L_thru3_ok:
s_lshl_b32 s23, s22, 7
s_sub_u32 s94, s53, s23
s_add_u32 s94, s94, 0x400000
s_lshl_b32 s23, s22, 9
s_sub_u32 s95, s57, s23
s_lshl_b32 s23, s22, 6
s_sub_u32 s96, s99, s23
s_mov_b64 exec, s[46:47]
ds_read_b128 v[160:163], v155 offset:0
ds_read_b128 v[176:179], v155 offset:2112
ds_read_b128 v[164:167], v155 offset:512
ds_read_b128 v[180:183], v155 offset:2624
ds_read_b128 v[168:171], v155 offset:1024
ds_read_b128 v[184:187], v155 offset:3136
ds_read_b128 v[172:175], v155 offset:1536
ds_read_b128 v[188:191], v155 offset:3648
s_waitcnt lgkmcnt(0)
buffer_store_dwordx4 v[176:179], v154, s[32:35], s96 offen offset:0 sc1
buffer_store_dwordx4 v[160:163], v10, s[32:35], s94 offen offset:0 sc1
buffer_store_dwordx4 v[180:183], v154, s[32:35], s96 offen offset:64 sc1
buffer_store_dwordx4 v[164:167], v10, s[32:35], s94 offen offset:128 sc1
buffer_store_dwordx4 v[184:187], v154, s[32:35], s96 offen offset:128 sc1
buffer_store_dwordx4 v[168:171], v10, s[32:35], s94 offen offset:256 sc1
buffer_store_dwordx4 v[188:191], v154, s[32:35], s96 offen offset:192 sc1
buffer_store_dwordx4 v[172:175], v10, s[32:35], s94 offen offset:384 sc1
s_mov_b64 exec, 15
v_lshlrev_b32 v192, 4, v0
v_add_u32 v192, 157600, v192
ds_read_b128 v[196:199], v192
v_lshlrev_b32 v193, 9, v0
s_waitcnt lgkmcnt(0)
v_lshlrev_b32 v194, 4, v0
s_andn2_b32 s94, s100, 0x30
buffer_store_dwordx4 v[196:199], v194, s[32:35], s94 offen sc1
buffer_store_dwordx4 v[196:199], v193, s[32:35], s95 offen sc1
s_mov_b64 exec, -1
s_waitcnt vmcnt(0)
L_pollo_n:
s_min_u32 s23, s42, 2097128
s_bitcmp1_b32 s23, 0
s_cselect_b32 s23, 0x400000, 0
s_andn2_b32 s54, s54, 0x400000
s_or_b32 s54, s54, s23
s_andn2_b32 s97, s97, 0x400000
s_or_b32 s97, s97, s23
s_sub_u32 s42, s42, 1
s_cbranch_scc0 L_pollo
s_endpgm
L_pollo_ok1:
v_pk_mul_f32 v[16:17], v[40:41], v[108:109] op_sel:[0,0] op_sel_hi:[1,0]
v_pk_mul_f32 v[18:19], v[42:43], v[108:109] op_sel:[0,0] op_sel_hi:[1,0]
v_pk_fma_f32 v[16:17], v[44:45], v[108:109], v[16:17] op_sel:[0,1,0] op_sel_hi:[1,1,1]
v_pk_fma_f32 v[18:19], v[46:47], v[108:109], v[18:19] op_sel:[0,1,0] op_sel_hi:[1,1,1]
v_pk_fma_f32 v[16:17], v[48:49], v[110:111], v[16:17] op_sel:[0,0,0] op_sel_hi:[1,0,1]
v_pk_fma_f32 v[18:19], v[50:51], v[110:111], v[18:19] op_sel:[0,0,0] op_sel_hi:[1,0,1]
v_pk_fma_f32 v[16:17], v[52:53], v[110:111], v[16:17] op_sel:[0,1,0] op_sel_hi:[1,1,1]
v_pk_fma_f32 v[18:19], v[54:55], v[110:111], v[18:19] op_sel:[0,1,0] op_sel_hi:[1,1,1]
s_branch L_pollo_done
L_pollo_ok0:
v_pk_mul_f32 v[16:17], v[24:25], v[108:109] op_sel:[0,0] op_sel_hi:[1,0]
v_pk_mul_f32 v[18:19], v[26:27], v[108:109] op_sel:[0,0] op_sel_hi:[1,0]
v_pk_fma_f32 v[16:17], v[28:29], v[108:109], v[16:17] op_sel:[0,1,0] op_sel_hi:[1,1,1]
v_pk_fma_f32 v[18:19], v[30:31], v[108:109], v[18:19] op_sel:[0,1,0] op_sel_hi:[1,1,1]
v_pk_fma_f32 v[16:17], v[32:33], v[110:111], v[16:17] op_sel:[0,0,0] op_sel_hi:[1,0,1]
v_pk_fma_f32 v[18:19], v[34:35], v[110:111], v[18:19] op_sel:[0,0,0] op_sel_hi:[1,0,1]
v_pk_fma_f32 v[16:17], v[36:37], v[110:111], v[16:17] op_sel:[0,1,0] op_sel_hi:[1,1,1]
v_pk_fma_f32 v[18:19], v[38:39], v[110:111], v[18:19] op_sel:[0,1,0] op_sel_hi:[1,1,1]
L_pollo_done:
v_cvt_pk_bf16_f32 v16, v16, v17
v_cvt_pk_bf16_f32 v17, v18, v19
ds_write_b64 v13, v[16:17]
s_waitcnt lgkmcnt(0)
s_barrier
ds_read_b128 v[96:99], v14 offset:0
ds_read_b64_tr_b16 v[112:113], v6 offset:0
ds_read_b64_tr_b16 v[114:115], v6 offset:512
ds_read_b128 v[100:103], v14 offset:64
ds_read_b64_tr_b16 v[116:117], v6 offset:4096
ds_read_b64_tr_b16 v[118:119], v6 offset:4608
ds_read_b128 v[104:107], v14 offset:128
ds_read_b64_tr_b16 v[120:121], v6 offset:8192
ds_read_b64_tr_b16 v[122:123], v6 offset:8704
ds_read_b128 v[108:111], v14 offset:192
ds_read_b64_tr_b16 v[124:125], v6 offset:12288
ds_read_b64_tr_b16 v[126:127], v6 offset:12800
s_waitcnt lgkmcnt(9)
v_mfma_f32_16x16x32_bf16 v[128:131], v[112:115], v[96:99], 0
s_waitcnt lgkmcnt(6)
v_mfma_f32_16x16x32_bf16 v[128:131], v[116:119], v[100:103], v[128:131]
s_waitcnt lgkmcnt(3)
v_mfma_f32_16x16x32_bf16 v[128:131], v[120:123], v[104:107], v[128:131]
s_waitcnt lgkmcnt(0)
v_mfma_f32_16x16x32_bf16 v[128:131], v[124:127], v[108:111], v[128:131]
s_nop 7
v_bfi_b32 v132, v143, v128, s37
v_bfi_b32 v133, v143, v129, s38
v_bfi_b32 v134, v143, v130, s39
v_bfi_b32 v135, v143, v131, s40
s_mov_b64 exec, s[46:47]
buffer_store_dwordx4 v[132:135], v15, s[32:35], s56 offen sc1
s_mov_b64 exec, -1
s_cmp_lg_u32 s22, 1
s_cbranch_scc1 L_nowb
s_cmp_lg_u32 s21, 31
s_cbranch_scc1 L_nowb
s_sleep 20
buffer_wbl2 sc1
s_waitcnt vmcnt(0)
L_nowb:
s_cmp_lg_u32 s22, 0
s_cbranch_scc1 L_Cend
v_lshrrev_b32 v2, 2, v0
v_lshlrev_b32 v2, 7, v2
v_and_b32 v140, 3, v0
v_lshl_add_u32 v2, v140, 4, v2
s_bfe_u32 s51, s2, 0x20004
s_lshl3_add_u32 s51, s51, s20
s_lshr_b32 s23, s2, 6
s_and_b32 s52, s21, 1
s_lshl_b32 s50, s23, 5
s_add_u32 s50, s50, s51
s_lshl_b32 s50, s50, 12
s_lshl_b32 s54, s52, 6
s_add_u32 s50, s50, s54
s_add_u32 s50, s50, 1179648
s_lshl1_add_u32 s52, s23, s52
s_lshl_b32 s52, s52, 10
s_lshl_b32 s51, s51, 5
s_add_u32 s52, s52, s51
s_mov_b32 s28, s14
s_mov_b32 s29, s15
s_mov_b32 s30, 0x2000
s_mov_b32 s31, 0x20000
v_lshlrev_b32 v3, 3, v140
v_bfe_u32 v4, v0, 4, 1
v_lshl_add_u32 v3, v4, 2, v3
v_lshrrev_b32 v4, 5, v0
v_lshl_add_u32 v3, v4, 1, v3
s_mov_b32 s44, 0xf000f
s_mov_b32 s45, 0xf000f
s_sleep 12
s_mov_b32 s42, 2097152
L_pollf:
buffer_load_dwordx4 v[96:99], v2, s[32:35], s50 offen offset:0 sc1
buffer_load_dwordx4 v[100:103], v2, s[32:35], s50 offen offset:2048 sc1
s_waitcnt vmcnt(0)
v_xor_b32 v96, s37, v96
v_xor_b32 v97, s38, v97
v_xor_b32 v98, s39, v98
v_xor_b32 v99, s40, v99
v_or3_b32 v140, v96, v97, v98
v_or_b32 v140, v140, v99
v_xor_b32 v100, s37, v100
v_xor_b32 v101, s38, v101
v_xor_b32 v102, s39, v102
v_xor_b32 v103, s40, v103
v_or3_b32 v140, v140, v100, v101
v_or3_b32 v140, v140, v102, v103
v_and_b32 v140, 0x3ff, v140
v_cmp_ne_u32 vcc, 0, v140
s_sub_u32 s42, s42, 1
s_cbranch_scc1 L_end
s_and_b64 exec, exec, vcc
s_cbranch_scc1 L_pollf
s_mov_b64 exec, -1
v_pk_add_f32 v[88:89], v[96:97], v[100:101]
v_pk_add_f32 v[90:91], v[98:99], v[102:103]
s_nop 1
v_permlane32_swap_b32 v88, v89
v_permlane32_swap_b32 v90, v91
v_add_f32 v88, v88, v89
v_add_f32 v90, v90, v91
s_nop 1
v_permlane16_swap_b32 v88, v90
v_add_f32 v88, v88, v90
s_nop 1
v_add_f32_dpp v88, v88, v88 row_ror:4 row_mask:0xf bank_mask:0xf
s_nop 1
v_add_f32_dpp v88, v88, v88 row_ror:8 row_mask:0xf bank_mask:0xf
v_mov_b32 v89, v88
s_nop 1
v_permlane32_swap_b32 v88, v89
v_cvt_pk_bf16_f32 v88, v88, v89
v_mov_b32 v89, v88
s_nop 1
v_permlane16_swap_b32 v88, v89
s_mov_b64 exec, 15
buffer_store_dwordx2 v[88:89], v3, s[28:31], s52 offen sc1
s_cmp_lg_u32 s2, 0
s_cbranch_scc1 L_Cend
s_mov_b64 exec, 1
v_mov_b32 v92, s36
v_mov_b32 v93, 0
buffer_store_dword v92, v93, s[32:35], 0 offen sc1
L_Cend:
s_endpgm
.p2align 6
L_L:
v_lshlrev_b32 v5, 10, v5
v_lshl_add_u32 v5, v6, 4, v5
s_lshl_b32 s23, s22, 2
v_add_u32 v6, s23, v2
v_xor_b32 v4, v6, v1
v_lshlrev_b32 v8, 8, v6
v_lshl_add_u32 v3, v4, 4, v8
s_and_b32 s23, s22, 2
s_lshl_b32 s23, s23, 2
v_lshlrev_b32 v7, 1, v2
v_or_b32 v7, s23, v7
v_xor_b32 v7, v7, v1
v_lshl_add_u32 v4, v7, 4, v8
s_lshr_b32 s43, s21, 2
s_and_b32 s44, s21, 3
s_lshl3_add_u32 s45, s43, s20
s_lshl_b32 s45, s45, 20
s_lshl_b32 s47, s44, 16
s_add_u32 s45, s45, s47
s_add_u32 s45, s45, 0xC0000
s_lshr_b32 s47, s2, 4
s_xor_b32 s47, s47, s2
s_lshl_b32 s47, s47, 12
s_and_b32 s47, s47, 0xffff
s_add_u32 m0, s46, 0
s_lshl2_add_u32 s51, s20, s95
s_lshl_b32 s51, s51, 17
s_lshl_b32 s52, s96, 7
s_add_u32 s51, s51, s52
v_mov_b32 v8, 150784
v_mov_b32 v10, 1
s_waitcnt lgkmcnt(0)
s_add_u32 s24, s6, s45
s_addc_u32 s25, s7, 0
s_mov_b32 s26, 0x10000
s_mov_b32 s27, 0x20000
s_add_u32 s28, s8, s45
s_addc_u32 s29, s9, 0
s_mov_b32 s30, 0x10000
s_mov_b32 s31, 0x20000
s_mov_b32 s32, s12
s_mov_b32 s33, s13
s_mov_b32 s34, 0x400000
s_mov_b32 s35, 0x20000
s_barrier
buffer_load_dwordx4 v3, s[24:27], s47 offen nt lds
s_add_u32 m0, m0, 4096
s_add_u32 s47, s47, 4096
s_and_b32 s47, s47, 0xffff
buffer_load_dwordx4 v3, s[24:27], s47 offen nt lds
s_add_u32 m0, m0, 4096
s_add_u32 s47, s47, 4096
s_and_b32 s47, s47, 0xffff
buffer_load_dwordx4 v3, s[24:27], s47 offen nt lds
s_add_u32 m0, m0, 4096
s_add_u32 s47, s47, 4096
s_and_b32 s47, s47, 0xffff
buffer_load_dwordx4 v3, s[24:27], s47 offen nt lds
s_add_u32 m0, m0, 4096
s_add_u32 s47, s47, 4096
s_and_b32 s47, s47, 0xffff
buffer_load_dwordx4 v3, s[24:27], s47 offen nt lds
s_add_u32 m0, m0, 4096
s_add_u32 s47, s47, 4096
s_and_b32 s47, s47, 0xffff
buffer_load_dwordx4 v3, s[24:27], s47 offen nt lds
s_add_u32 m0, m0, 4096
s_add_u32 s47, s47, 4096
s_and_b32 s47, s47, 0xffff
buffer_load_dwordx4 v3, s[24:27], s47 offen nt lds
s_add_u32 m0, m0, 4096
s_add_u32 s47, s47, 4096
s_and_b32 s47, s47, 0xffff
s_waitcnt vmcnt(6)
buffer_load_dwordx4 v3, s[24:27], s47 offen nt lds
s_add_u32 m0, m0, 4096
s_add_u32 s47, s47, 4096
s_and_b32 s47, s47, 0xffff
s_waitcnt vmcnt(6)
buffer_load_dwordx4 v3, s[24:27], s47 offen nt lds
s_add_u32 m0, m0, 4096
s_add_u32 s47, s47, 4096
s_and_b32 s47, s47, 0xffff
s_waitcnt vmcnt(6)
buffer_load_dwordx4 v3, s[24:27], s47 offen nt lds
s_add_u32 m0, m0, 4096
s_add_u32 s47, s47, 4096
s_and_b32 s47, s47, 0xffff
s_waitcnt vmcnt(6)
buffer_load_dwordx4 v3, s[24:27], s47 offen nt lds
s_add_u32 m0, m0, 4096
s_add_u32 s47, s47, 4096
s_and_b32 s47, s47, 0xffff
s_waitcnt vmcnt(6)
buffer_load_dwordx4 v3, s[24:27], s47 offen nt lds
s_add_u32 m0, m0, 4096
s_add_u32 s47, s47, 4096
s_and_b32 s47, s47, 0xffff
s_waitcnt vmcnt(6)
buffer_load_dwordx4 v3, s[24:27], s47 offen nt lds
s_add_u32 m0, m0, 4096
s_add_u32 s47, s47, 4096
s_and_b32 s47, s47, 0xffff
s_waitcnt vmcnt(6)
buffer_load_dwordx4 v3, s[24:27], s47 offen nt lds
s_add_u32 m0, m0, 4096
s_add_u32 s47, s47, 4096
s_and_b32 s47, s47, 0xffff
s_waitcnt vmcnt(6)
buffer_load_dwordx4 v3, s[24:27], s47 offen nt lds
s_add_u32 m0, m0, 4096
s_add_u32 s47, s47, 4096
s_and_b32 s47, s47, 0xffff
s_waitcnt vmcnt(6)
buffer_load_dwordx4 v3, s[24:27], s47 offen nt lds
s_add_u32 m0, m0, 4096
s_add_u32 s47, s47, 4096
s_and_b32 s47, s47, 0xffff
s_waitcnt vmcnt(6)
buffer_load_dwordx4 v4, s[28:31], s47 offen nt lds
s_add_u32 m0, m0, 4096
s_add_u32 s47, s47, 4096
s_and_b32 s47, s47, 0xffff
s_waitcnt vmcnt(6)
buffer_load_dwordx4 v4, s[28:31], s47 offen nt lds
s_add_u32 m0, m0, 4096
s_add_u32 s47, s47, 4096
s_and_b32 s47, s47, 0xffff
s_waitcnt vmcnt(6)
buffer_load_dwordx4 v4, s[28:31], s47 offen nt lds
s_add_u32 m0, m0, 4096
s_add_u32 s47, s47, 4096
s_and_b32 s47, s47, 0xffff
s_waitcnt vmcnt(6)
buffer_load_dwordx4 v4, s[28:31], s47 offen nt lds
s_add_u32 m0, m0, 4096
s_add_u32 s47, s47, 4096
s_and_b32 s47, s47, 0xffff
s_waitcnt vmcnt(6)
buffer_load_dwordx4 v4, s[28:31], s47 offen nt lds
s_add_u32 m0, m0, 4096
s_add_u32 s47, s47, 4096
s_and_b32 s47, s47, 0xffff
s_waitcnt vmcnt(6)
buffer_load_dwordx4 v4, s[28:31], s47 offen nt lds
s_add_u32 m0, m0, 4096
s_add_u32 s47, s47, 4096
s_and_b32 s47, s47, 0xffff
s_waitcnt vmcnt(6)
s_mov_b64 exec, 1
ds_add_u32 v8, v10 offset:4
s_mov_b64 exec, -1
buffer_load_dwordx4 v4, s[28:31], s47 offen nt lds
s_add_u32 m0, m0, 4096
s_add_u32 s47, s47, 4096
s_and_b32 s47, s47, 0xffff
s_waitcnt vmcnt(6)
buffer_load_dwordx4 v4, s[28:31], s47 offen nt lds
s_add_u32 m0, m0, 4096
s_add_u32 s47, s47, 4096
s_and_b32 s47, s47, 0xffff
s_waitcnt vmcnt(6)
buffer_load_dwordx4 v4, s[28:31], s47 offen nt lds
s_add_u32 m0, m0, 4096
s_add_u32 s47, s47, 4096
s_and_b32 s47, s47, 0xffff
s_waitcnt vmcnt(6)
buffer_load_dwordx4 v4, s[28:31], s47 offen nt lds
s_add_u32 m0, m0, 4096
s_add_u32 s47, s47, 4096
s_and_b32 s47, s47, 0xffff
s_waitcnt vmcnt(6)
buffer_load_dwordx4 v4, s[28:31], s47 offen nt lds
s_add_u32 m0, m0, 4096
s_add_u32 s47, s47, 4096
s_and_b32 s47, s47, 0xffff
s_waitcnt vmcnt(6)
buffer_load_dwordx4 v4, s[28:31], s47 offen nt lds
s_add_u32 m0, m0, 4096
s_add_u32 s47, s47, 4096
s_and_b32 s47, s47, 0xffff
s_waitcnt vmcnt(6)
buffer_load_dwordx4 v4, s[28:31], s47 offen nt lds
s_add_u32 m0, m0, 4096
s_add_u32 s47, s47, 4096
s_and_b32 s47, s47, 0xffff
s_waitcnt vmcnt(6)
buffer_load_dwordx4 v4, s[28:31], s47 offen nt lds
s_add_u32 m0, m0, 4096
s_add_u32 s47, s47, 4096
s_and_b32 s47, s47, 0xffff
s_waitcnt vmcnt(6)
s_mov_b64 exec, 1
ds_add_u32 v8, v10 offset:8
s_mov_b64 exec, -1
buffer_load_dwordx4 v4, s[28:31], s47 offen nt lds
s_add_u32 m0, m0, 4096
s_add_u32 s47, s47, 4096
s_and_b32 s47, s47, 0xffff
s_waitcnt vmcnt(6)
buffer_load_dwordx4 v4, s[28:31], s47 offen nt lds
s_add_u32 m0, s46, 131072
s_nop 0
s_waitcnt vmcnt(6)
s_mov_b32 s42, 2097152
L_spinwo:
ds_read_b32 v9, v8 offset:20
s_sub_u32 s42, s42, 1
s_cbranch_scc1 L_end
s_waitcnt lgkmcnt(0)
v_cmp_gt_u32 vcc, 4, v9
s_cbranch_vccz L_spinwo_ok
s_sleep 1
s_branch L_spinwo
L_spinwo_ok:
buffer_load_dwordx4 v5, s[32:35], s51 offen nt lds
s_add_u32 m0, m0, 4096
s_add_u32 s51, s51, 32768
s_waitcnt vmcnt(6)
buffer_load_dwordx4 v5, s[32:35], s51 offen nt lds
s_add_u32 m0, m0, 4096
s_add_u32 s51, s51, 32768
s_waitcnt vmcnt(6)
s_mov_b64 exec, 1
ds_add_u32 v8, v10 offset:12
s_mov_b64 exec, -1
buffer_load_dwordx4 v5, s[32:35], s51 offen nt lds
s_add_u32 m0, m0, 4096
s_add_u32 s51, s51, 32768
s_waitcnt vmcnt(6)
buffer_load_dwordx4 v5, s[32:35], s51 offen nt lds
s_waitcnt vmcnt(4)
s_barrier
s_waitcnt vmcnt(0)
s_barrier
L_end:
s_endpgm
.section .rodata,"a"
.p2align 6
.amdhsa_kernel standalone__sliding_block_cached__decode_kernel
  .amdhsa_next_free_vgpr 200
  .amdhsa_next_free_sgpr 102
  .amdhsa_accum_offset 200
  .amdhsa_group_segment_fixed_size 0
  .amdhsa_kernarg_size 64
  .amdhsa_user_sgpr_count 2
  .amdhsa_user_sgpr_kernarg_segment_ptr 1
  .amdhsa_system_sgpr_workgroup_id_x 1
.end_amdhsa_kernel
```
